```python
import torch

def _softmax(x, axis=-1):
    return torch.softmax(x, dim=axis)

def _gelu(x):
    return torch.nn.functional.gelu(x, approximate='tanh')

def _silu(x):
    return torch.nn.functional.silu(x)

def _sigmoid(x):
    return torch.sigmoid(x)

def _layernorm(x, axis=-1, eps=1e-05):
    m = x.mean(dim=axis, keepdim=True)
    v = x.var(dim=axis, keepdim=True, unbiased=False)
    return (x - m) / torch.sqrt(v + eps)

def _scatter_add(tgt, idx, src, axis=0):
    return tgt.clone().index_add_(axis, idx, src)

def _segment_sum(src, seg, n):
    out = torch.zeros((n,) + src.shape[1:], dtype=src.dtype)
    return out.index_add_(0, seg, src)

def _pad(x, pw):
    flat = tuple((v for pair in reversed(pw) for v in pair))
    return torch.nn.functional.pad(x, flat)
kernel_name = 'standalone__tree_speculative_verify_tree_attention_over_candidate_token_tree__decode'

def setup_inputs():

    _w = lambda a: (lambda t: t.to(torch.bfloat16) if t.is_floating_point() else t)(torch.as_tensor(a))
    B, Hq, Hkv, T, C, D = (1, 32, 32, 1, 4096, 128)
    tree_mask = torch.zeros((B, T, T), dtype=float)
    for b in range(B):
        parent = torch.zeros(T, dtype=torch.int64)
        for i in range(1, T):
            parent[i] = int(torch.randint(0, i, (1,)).item())
        for i in range(T):
            j = i
            tree_mask[b, i, j] = 1.0
            while j > 0:
                j = parent[j]
                tree_mask[b, i, j] = 1.0
    return {'q': _w((lambda *s: torch.randn(*s, dtype=torch.bfloat16) * 0.8)(B, Hq, T, D)), 'k_cache': _w((lambda *s: torch.randn(*s, dtype=torch.bfloat16) * 0.8)(B, Hkv, C, D)), 'v_cache': _w((lambda *s: torch.randn(*s, dtype=torch.bfloat16) * 0.05)(B, Hkv, C, D)), 'k_tree': _w((lambda *s: torch.randn(*s, dtype=torch.bfloat16) * 0.8)(B, Hkv, T, D)), 'v_tree': _w((lambda *s: torch.randn(*s, dtype=torch.bfloat16) * 0.05)(B, Hkv, T, D)), 'tree_mask': _w(tree_mask)}

def reference(q, k_cache, v_cache, k_tree, v_tree, tree_mask):
    B, Hq, T, D = q.shape
    Hkv, C = (k_cache.shape[1], k_cache.shape[2])
    rep = Hq // Hkv
    kc = (lambda x, n, axis: torch.repeat_interleave(x, n, dim=axis))(k_cache, rep, axis=1)
    vc = (lambda x, n, axis: torch.repeat_interleave(x, n, dim=axis))(v_cache, rep, axis=1)
    kt = (lambda x, n, axis: torch.repeat_interleave(x, n, dim=axis))(k_tree, rep, axis=1)
    vt = (lambda x, n, axis: torch.repeat_interleave(x, n, dim=axis))(v_tree, rep, axis=1)
    k = torch.concatenate([kc, kt], axis=2)
    v = torch.concatenate([vc, vt], axis=2)
    scale = D ** (-0.5)
    scores = torch.einsum('bhqd,bhkd->bhqk', q, k) * scale
    ctx_mask = torch.ones((B, 1, T, C), dtype=scores.dtype)
    tm = tree_mask[:, None, :, :].clone()
    full_mask = torch.concatenate([ctx_mask, tm], axis=-1)
    scores = scores + (1.0 - full_mask) * -1000000000.0
    p = _softmax(scores, axis=-1)
    return torch.einsum('bhqk,bhkd->bhqd', p, v)
```

```asm
; @launch grid=(256,1,1) block=(320,1,1) lds=4352
.amdgcn_target "amdgcn-amd-amdhsa--gfx950"
.text
.globl standalone__tree_speculative_verify_tree_attention_over_candidate_token_tree__decode_kernel
.p2align 12
L_text0:
.p2align 8
.type standalone__tree_speculative_verify_tree_attention_over_candidate_token_tree__decode_kernel,@function
standalone__tree_speculative_verify_tree_attention_over_candidate_token_tree__decode_kernel:
  s_load_dwordx8 s[4:11], s[0:1], 0
  v_lshrrev_b32 v10, 6, v0
  s_cmp_ge_u32 s2, 256
  s_cbranch_scc1 L_end
  v_readfirstlane_b32 s26, v10
  v_and_b32 v9, 63, v0
  s_and_b32 s22, s2, 7
  s_lshl_b32 s22, s22, 5
  s_lshr_b32 s23, s2, 3
  s_or_b32 s22, s22, s23
  v_bfe_i32 v11, v0, 2, 1
  v_lshlrev_b32 v12, 2, v9
  ds_write_b32 v12, v11
  s_bitcmp1_b32 s22, 0
  s_cselect_b32 s24, 0x58d00, 0
  s_bitcmp1_b32 s22, 1
  s_cselect_b32 s28, 0xea600, 0
  s_xor_b32 s24, s24, s28
  s_bitcmp1_b32 s22, 2
  s_cselect_b32 s28, 0x1fa00, 0
  s_xor_b32 s24, s24, s28
  s_bitcmp1_b32 s22, 3
  s_cselect_b32 s28, 0x21a900, 0
  s_xor_b32 s24, s24, s28
  s_bitcmp1_b32 s22, 4
  s_cselect_b32 s28, 0x402500, 0
  s_xor_b32 s24, s24, s28
  s_bitcmp1_b32 s22, 5
  s_cselect_b32 s28, 0x80dd00, 0
  s_xor_b32 s24, s24, s28
  s_bitcmp1_b32 s22, 6
  s_cselect_b32 s28, 0x714b00, 0
  s_xor_b32 s24, s24, s28
  s_bitcmp1_b32 s22, 7
  s_cselect_b32 s28, 0x1f9f500, 0
  s_xor_b32 s24, s24, s28
  s_lshr_b32 s25, s24, 20
  s_cmp_eq_u32 s26, 4
  s_cbranch_scc1 L_H
  s_bitcmp1_b32 s26, 0
  s_cselect_b32 s28, 0x200, 0
  s_xor_b32 s24, s24, s28
  s_bitcmp1_b32 s26, 1
  s_cselect_b32 s28, 0x41f00, 0
  s_xor_b32 s24, s24, s28
  v_and_b32 v10, 3, v0
  v_lshl_add_u32 v1, v10, 4, s24
  v_bfe_u32 v11, v0, 4, 2
  v_lshl_add_u32 v1, v11, 6, v1
  v_bfe_i32 v11, v0, 2, 1
  v_and_b32 v11, 0x46d00, v11
  v_xor_b32 v1, v11, v1
  v_bfe_i32 v11, v0, 3, 1
  v_and_b32 v11, 0x2000, v11
  v_xor_b32 v1, v11, v1
  s_lshl_b32 s28, s25, 8
  v_lshrrev_b32 v12, 2, v9
  v_lshl_add_u32 v12, v12, 4, s28
  s_waitcnt lgkmcnt(0)
  global_load_dwordx4 v[72:75], v1, s[6:7] nt
  s_mov_b32 s56, 0x57f00
  v_xor_b32 v2, s56, v1
  global_load_dwordx4 v[76:79], v2, s[6:7] nt
  s_mov_b32 s57, 0x4a600
  v_xor_b32 v3, s57, v2
  global_load_dwordx4 v[80:83], v3, s[6:7] nt
  v_xor_b32 v4, s56, v3
  global_load_dwordx4 v[84:87], v4, s[6:7] nt
  s_mov_b32 s58, 0x3f700
  v_xor_b32 v1, s58, v4
  global_load_dwordx4 v[88:91], v1, s[6:7] nt
  v_xor_b32 v2, s56, v1
  global_load_dwordx4 v[92:95], v2, s[6:7] nt
  global_load_dwordx4 v[68:71], v12, s[4:5]
  v_xor_b32 v3, s57, v2
  global_load_dwordx4 v[96:99], v3, s[6:7] nt
  v_xor_b32 v4, s56, v3
  global_load_dwordx4 v[100:103], v4, s[6:7] nt
  s_load_dwordx4 s[16:19], s[0:1], 56
  v_and_b32 v11, 15, v0
  s_xor_b32 s24, s24, 0x1f300
  v_lshl_add_u32 v5, v11, 4, s24
  v_bfe_i32 v13, v0, 4, 1
  v_and_b32 v13, 0x46d00, v13
  v_xor_b32 v5, v13, v5
  v_bfe_i32 v13, v0, 5, 1
  v_and_b32 v13, 0x2000, v13
  v_xor_b32 v5, v13, v5
  v_and_b32 v13, 1, v0
  v_lshlrev_b32 v13, 4, v13
  v_mov_b32 v14, 0xffff
  v_lshlrev_b32 v13, v13, v14
  v_lshrrev_b32 v14, 1, v11
  v_cmp_eq_u32 s[40:41], 0, v14
  v_cmp_eq_u32 s[42:43], 1, v14
  v_cmp_eq_u32 s[44:45], 2, v14
  v_cmp_eq_u32 s[46:47], 3, v14
  v_cmp_eq_u32 s[48:49], 0, v10
  v_cmp_eq_u32 s[50:51], 1, v10
  v_cmp_eq_u32 s[52:53], 2, v10
  v_cmp_eq_u32 s[54:55], 3, v10
  v_cndmask_b32 v44, 0, v13, s[40:41]
  v_cndmask_b32 v45, 0, v13, s[42:43]
  v_cndmask_b32 v46, 0, v13, s[44:45]
  v_cndmask_b32 v47, 0, v13, s[46:47]
  v_mov_b32 v60, 1
  v_mov_b32 v61, 0
  s_lshl_b32 s28, s26, 9
  v_lshlrev_b32 v64, 3, v9
  v_add_u32 v62, s28, v64
  v_bfe_u32 v13, v0, 4, 1
  v_lshlrev_b32 v13, 4, v13
  v_lshl_add_u32 v13, v11, 5, v13
  v_add_u32 v63, s28, v13
  s_lshl_b32 s28, s25, 13
  s_and_b32 s29, s22, 7
  s_lshl_b32 s30, s29, 9
  s_add_u32 s28, s28, s30
  s_load_dwordx2 s[32:33], s[0:1], 48
  v_add_u32 v67, s28, v64
  s_lshl_b32 s28, s25, 13
  s_lshl_b32 s30, s29, 6
  s_add_u32 s28, s28, s30
  v_and_b32 v13, 7, v0
  v_lshl_add_u32 v65, v13, 3, s28
  v_lshrrev_b32 v14, 3, v9
  v_lshl_add_u32 v65, v14, 9, v65
  s_lshl_b32 s28, s25, 8
  s_lshl_b32 s30, s29, 5
  s_add_u32 s28, s28, s30
  v_lshl_add_u32 v15, v13, 2, s28
  v_lshrrev_b32 v14, 5, v9
  v_lshl_add_u32 v15, v14, 1, v15
  s_lshl_b32 s28, s25, 13
  s_add_u32 s28, s28, 4096
  v_bfe_u32 v13, v0, 3, 2
  v_lshl_add_u32 v14, v13, 4, s28
  s_mov_b32 s31, 0x3e0293ee
  s_lshl_b32 s28, s25, 2
  v_mov_b32 v66, s28
  s_barrier
  v_xor_b32 v1, 0x1f300, v4
  global_load_dwordx4 v[104:107], v1, s[6:7] nt
  v_xor_b32 v2, s56, v1
  global_load_dwordx4 v[108:111], v2, s[6:7] nt
  v_xor_b32 v3, s57, v2
  global_load_dwordx4 v[112:115], v3, s[6:7] nt
  v_xor_b32 v4, s56, v3
  global_load_dwordx4 v[116:119], v4, s[6:7] nt
  v_xor_b32 v1, s58, v4
  global_load_dwordx4 v[120:123], v1, s[6:7] nt
  v_xor_b32 v2, s56, v1
  global_load_dwordx4 v[124:127], v2, s[6:7] nt
  v_xor_b32 v3, s57, v2
  global_load_dwordx4 v[128:131], v3, s[6:7] nt
  v_xor_b32 v4, s56, v3
  global_load_dwordx4 v[132:135], v4, s[6:7] nt
  v_xor_b32 v1, 0x54000, v4
  global_load_dwordx4 v[136:139], v1, s[6:7] nt
  v_xor_b32 v2, s56, v1
  global_load_dwordx4 v[140:143], v2, s[6:7] nt
  v_xor_b32 v3, s57, v2
  global_load_dwordx4 v[144:147], v3, s[6:7] nt
  v_xor_b32 v4, s56, v3
  global_load_dwordx4 v[148:151], v4, s[6:7] nt
  v_xor_b32 v1, s58, v4
  global_load_dwordx4 v[152:155], v1, s[6:7] nt
  s_waitcnt vmcnt(15)
  v_cndmask_b32 v16, 0, v68, s[48:49]
  v_cndmask_b32 v17, 0, v69, s[48:49]
  v_cndmask_b32 v18, 0, v70, s[48:49]
  v_cndmask_b32 v19, 0, v71, s[48:49]
  v_cndmask_b32 v20, 0, v68, s[50:51]
  v_cndmask_b32 v21, 0, v69, s[50:51]
  v_cndmask_b32 v22, 0, v70, s[50:51]
  v_cndmask_b32 v23, 0, v71, s[50:51]
  v_cndmask_b32 v24, 0, v68, s[52:53]
  v_cndmask_b32 v25, 0, v69, s[52:53]
  v_cndmask_b32 v26, 0, v70, s[52:53]
  v_cndmask_b32 v27, 0, v71, s[52:53]
  v_cndmask_b32 v28, 0, v68, s[54:55]
  v_cndmask_b32 v29, 0, v69, s[54:55]
  v_cndmask_b32 v30, 0, v70, s[54:55]
  v_cndmask_b32 v31, 0, v71, s[54:55]
  s_waitcnt vmcnt(21)
  v_mfma_f32_16x16x32_bf16 v[32:35], v[72:75], v[16:19], 0
  v_xor_b32 v2, s56, v1
  global_load_dwordx4 v[156:159], v2, s[6:7] nt
  s_waitcnt vmcnt(21)
  v_mfma_f32_16x16x32_bf16 v[32:35], v[76:79], v[20:23], v[32:35]
  v_xor_b32 v3, s57, v2
  global_load_dwordx4 v[72:75], v3, s[6:7] nt
  s_waitcnt vmcnt(21)
  v_mfma_f32_16x16x32_bf16 v[32:35], v[80:83], v[24:27], v[32:35]
  v_xor_b32 v4, s56, v3
  global_load_dwordx4 v[76:79], v4, s[6:7] nt
  s_waitcnt vmcnt(21)
  v_mfma_f32_16x16x32_bf16 v[32:35], v[84:87], v[28:31], v[32:35]
  v_xor_b32 v1, 0x1f300, v4
  global_load_dwordx4 v[80:83], v1, s[6:7] nt
  s_waitcnt vmcnt(21)
  v_mfma_f32_16x16x32_bf16 v[36:39], v[88:91], v[16:19], 0
  v_xor_b32 v2, s56, v1
  global_load_dwordx4 v[84:87], v2, s[6:7] nt
  s_waitcnt vmcnt(21)
  v_mfma_f32_16x16x32_bf16 v[36:39], v[92:95], v[20:23], v[36:39]
  v_add_f32_dpp v40, v33, v32 row_ror:12 row_mask:0xf bank_mask:0x1
  v_xor_b32 v3, s57, v2
  global_load_dwordx4 v[88:91], v3, s[6:7] nt
  s_waitcnt vmcnt(20)
  v_mfma_f32_16x16x32_bf16 v[36:39], v[96:99], v[24:27], v[36:39]
  v_add_f32_dpp v40, v34, v40 row_ror:8 row_mask:0xf bank_mask:0x1
  v_xor_b32 v4, s56, v3
  global_load_dwordx4 v[92:95], v4, s[6:7] nt
  s_waitcnt vmcnt(20)
  v_mfma_f32_16x16x32_bf16 v[36:39], v[100:103], v[28:31], v[36:39]
  v_add_f32_dpp v40, v35, v40 row_ror:4 row_mask:0xf bank_mask:0x1
  v_xor_b32 v1, s58, v4
  global_load_dwordx4 v[96:99], v1, s[6:7] nt
  s_waitcnt lgkmcnt(0)
  global_load_dword v66, v66, s[16:17] sc1
  s_waitcnt vmcnt(21)
  v_mfma_f32_16x16x32_bf16 v[32:35], v[104:107], v[16:19], 0
  v_xor_b32 v2, s56, v1
  global_load_dwordx4 v[100:103], v2, s[6:7] nt
  s_waitcnt vmcnt(21)
  v_mfma_f32_16x16x32_bf16 v[32:35], v[108:111], v[20:23], v[32:35]
  v_add_f32_dpp v40, v36, v37 row_ror:4 row_mask:0xf bank_mask:0x2
  v_xor_b32 v3, s57, v2
  global_load_dwordx4 v[104:107], v3, s[6:7] nt
  s_waitcnt vmcnt(21)
  v_mfma_f32_16x16x32_bf16 v[32:35], v[112:115], v[24:27], v[32:35]
  v_add_f32_dpp v40, v38, v40 row_ror:12 row_mask:0xf bank_mask:0x2
  v_xor_b32 v4, s56, v3
  global_load_dwordx4 v[108:111], v4, s[6:7] nt
  s_waitcnt vmcnt(21)
  v_mfma_f32_16x16x32_bf16 v[32:35], v[116:119], v[28:31], v[32:35]
  v_add_f32_dpp v40, v39, v40 row_ror:8 row_mask:0xf bank_mask:0x2
  global_load_dwordx4 v[112:115], v5, s[8:9] nt
  s_waitcnt vmcnt(21)
  v_mfma_f32_16x16x32_bf16 v[36:39], v[120:123], v[16:19], 0
  v_xor_b32 v6, s56, v5
  global_load_dwordx4 v[116:119], v6, s[8:9] nt
  s_waitcnt vmcnt(21)
  v_mfma_f32_16x16x32_bf16 v[36:39], v[124:127], v[20:23], v[36:39]
  v_add_f32_dpp v40, v32, v34 row_ror:8 row_mask:0xf bank_mask:0x4
  v_xor_b32 v7, s57, v6
  global_load_dwordx4 v[120:123], v7, s[8:9] nt
  s_waitcnt vmcnt(21)
  v_mfma_f32_16x16x32_bf16 v[36:39], v[128:131], v[24:27], v[36:39]
  v_add_f32_dpp v40, v33, v40 row_ror:4 row_mask:0xf bank_mask:0x4
  v_xor_b32 v8, s56, v7
  global_load_dwordx4 v[124:127], v8, s[8:9] nt
  s_waitcnt vmcnt(21)
  v_mfma_f32_16x16x32_bf16 v[36:39], v[132:135], v[28:31], v[36:39]
  v_add_f32_dpp v40, v35, v40 row_ror:12 row_mask:0xf bank_mask:0x4
  v_xor_b32 v5, s58, v8
  global_load_dwordx4 v[128:131], v5, s[8:9] nt
  s_waitcnt vmcnt(21)
  v_mfma_f32_16x16x32_bf16 v[32:35], v[136:139], v[16:19], 0
  v_xor_b32 v6, s56, v5
  global_load_dwordx4 v[132:135], v6, s[8:9] nt
  s_waitcnt vmcnt(21)
  v_mfma_f32_16x16x32_bf16 v[32:35], v[140:143], v[20:23], v[32:35]
  v_add_f32_dpp v40, v36, v39 row_ror:12 row_mask:0xf bank_mask:0x8
  v_xor_b32 v7, s57, v6
  global_load_dwordx4 v[136:139], v7, s[8:9] nt
  s_waitcnt vmcnt(21)
  v_mfma_f32_16x16x32_bf16 v[32:35], v[144:147], v[24:27], v[32:35]
  v_add_f32_dpp v40, v37, v40 row_ror:8 row_mask:0xf bank_mask:0x8
  v_xor_b32 v8, s56, v7
  global_load_dwordx4 v[140:143], v8, s[8:9] nt
  s_waitcnt vmcnt(21)
  v_mfma_f32_16x16x32_bf16 v[32:35], v[148:151], v[28:31], v[32:35]
  v_add_f32_dpp v40, v38, v40 row_ror:4 row_mask:0xf bank_mask:0x8
  v_xor_b32 v5, 0x1f300, v8
  global_load_dwordx4 v[144:147], v5, s[8:9] nt
  s_waitcnt vmcnt(21)
  v_mfma_f32_16x16x32_bf16 v[36:39], v[152:155], v[16:19], 0
  v_xor_b32 v6, s56, v5
  global_load_dwordx4 v[148:151], v6, s[8:9] nt
  s_waitcnt vmcnt(21)
  v_mfma_f32_16x16x32_bf16 v[36:39], v[156:159], v[20:23], v[36:39]
  v_add_f32_dpp v41, v33, v32 row_ror:12 row_mask:0xf bank_mask:0x1
  v_xor_b32 v7, s57, v6
  global_load_dwordx4 v[152:155], v7, s[8:9] nt
  s_waitcnt vmcnt(21)
  v_mfma_f32_16x16x32_bf16 v[36:39], v[72:75], v[24:27], v[36:39]
  v_add_f32_dpp v41, v34, v41 row_ror:8 row_mask:0xf bank_mask:0x1
  v_xor_b32 v8, s56, v7
  global_load_dwordx4 v[156:159], v8, s[8:9] nt
  s_waitcnt vmcnt(21)
  v_mfma_f32_16x16x32_bf16 v[36:39], v[76:79], v[28:31], v[36:39]
  v_add_f32_dpp v41, v35, v41 row_ror:4 row_mask:0xf bank_mask:0x1
  v_xor_b32 v5, s58, v8
  global_load_dwordx4 v[72:75], v5, s[8:9] nt
  s_waitcnt vmcnt(21)
  v_mfma_f32_16x16x32_bf16 v[32:35], v[80:83], v[16:19], 0
  v_xor_b32 v6, s56, v5
  global_load_dwordx4 v[76:79], v6, s[8:9] nt
  s_waitcnt vmcnt(21)
  v_mfma_f32_16x16x32_bf16 v[32:35], v[84:87], v[20:23], v[32:35]
  v_add_f32_dpp v41, v36, v37 row_ror:4 row_mask:0xf bank_mask:0x2
  v_xor_b32 v7, s57, v6
  global_load_dwordx4 v[80:83], v7, s[8:9] nt
  s_waitcnt vmcnt(21)
  v_mfma_f32_16x16x32_bf16 v[32:35], v[88:91], v[24:27], v[32:35]
  v_add_f32_dpp v41, v38, v41 row_ror:12 row_mask:0xf bank_mask:0x2
  v_xor_b32 v8, s56, v7
  global_load_dwordx4 v[84:87], v8, s[8:9] nt
  s_waitcnt vmcnt(21)
  v_mfma_f32_16x16x32_bf16 v[32:35], v[92:95], v[28:31], v[32:35]
  v_add_f32_dpp v41, v39, v41 row_ror:8 row_mask:0xf bank_mask:0x2
  v_xor_b32 v5, 0x54000, v8
  global_load_dwordx4 v[88:91], v5, s[8:9] nt
  s_waitcnt vmcnt(21)
  v_mfma_f32_16x16x32_bf16 v[36:39], v[96:99], v[16:19], 0
  v_xor_b32 v6, s56, v5
  global_load_dwordx4 v[92:95], v6, s[8:9] nt
  s_waitcnt vmcnt(20)
  v_mfma_f32_16x16x32_bf16 v[36:39], v[100:103], v[20:23], v[36:39]
  v_add_f32_dpp v41, v32, v34 row_ror:8 row_mask:0xf bank_mask:0x4
  v_xor_b32 v7, s57, v6
  global_load_dwordx4 v[96:99], v7, s[8:9] nt
  s_waitcnt vmcnt(20)
  v_mfma_f32_16x16x32_bf16 v[36:39], v[104:107], v[24:27], v[36:39]
  v_add_f32_dpp v41, v33, v41 row_ror:4 row_mask:0xf bank_mask:0x4
  v_xor_b32 v8, s56, v7
  global_load_dwordx4 v[100:103], v8, s[8:9] nt
  s_waitcnt vmcnt(20)
  v_mfma_f32_16x16x32_bf16 v[36:39], v[108:111], v[28:31], v[36:39]
  v_add_f32_dpp v41, v35, v41 row_ror:12 row_mask:0xf bank_mask:0x4
  s_nop 6
  v_add_f32_dpp v41, v36, v39 row_ror:12 row_mask:0xf bank_mask:0x8
  s_nop 1
  v_add_f32_dpp v41, v37, v41 row_ror:8 row_mask:0xf bank_mask:0x8
  s_nop 1
  v_add_f32_dpp v41, v38, v41 row_ror:4 row_mask:0xf bank_mask:0x8
  v_max_f32 v42, v40, v41
  s_nop 1
  v_max_f32_dpp v42, v42, v42 row_ror:8 row_mask:0xf bank_mask:0xf
  s_nop 1
  v_max_f32_dpp v42, v42, v42 row_ror:4 row_mask:0xf bank_mask:0xf
  s_nop 1
  v_max_f32_dpp v42, v42, v42 row_ror:2 row_mask:0xf bank_mask:0xf
  s_nop 1
  v_max_f32_dpp v42, v42, v42 row_ror:1 row_mask:0xf bank_mask:0xf
  v_mov_b32 v10, v42
  s_nop 1
  v_permlane16_swap_b32 v10, v42
  v_max_f32 v42, v42, v10
  v_mov_b32 v10, v42
  s_nop 1
  v_permlane32_swap_b32 v10, v42
  v_max_f32 v42, v42, v10
  v_mul_f32 v42, s31, v42
  v_fma_f32 v40, v40, s31, -v42
  v_fma_f32 v41, v41, s31, -v42
  v_exp_f32 v40, v40
  v_exp_f32 v41, v41
  s_nop 0
  v_add_f32 v43, v40, v41
  v_cvt_pk_bf16_f32 v40, v40, v40
  v_cvt_pk_bf16_f32 v41, v41, v41
  ds_write_b64 v62, v[42:43] offset:256
  s_mov_b64 exec, 1
  ds_and_b32 v61, v66 offset:52
  ds_add_u32 v61, v60 offset:48
  s_mov_b64 exec, -1
  v_and_b32_dpp v48, v40, v44 row_newbcast:15 row_mask:0xf bank_mask:0xf
  v_and_b32_dpp v49, v40, v45 row_newbcast:15 row_mask:0xf bank_mask:0xf
  v_and_b32_dpp v50, v40, v46 row_newbcast:15 row_mask:0xf bank_mask:0xf
  v_and_b32_dpp v51, v40, v47 row_newbcast:15 row_mask:0xf bank_mask:0xf
  v_xor_b32 v5, s58, v8
  global_load_dwordx4 v[104:107], v5, s[8:9] nt
  v_and_b32_dpp v52, v40, v44 row_newbcast:14 row_mask:0xf bank_mask:0xf
  v_and_b32_dpp v53, v40, v45 row_newbcast:14 row_mask:0xf bank_mask:0xf
  v_and_b32_dpp v54, v40, v46 row_newbcast:14 row_mask:0xf bank_mask:0xf
  v_and_b32_dpp v55, v40, v47 row_newbcast:14 row_mask:0xf bank_mask:0xf
  s_waitcnt vmcnt(20)
  v_mfma_f32_16x16x32_bf16 v[56:59], v[48:51], v[112:115], 0
  v_xor_b32 v6, s56, v5
  global_load_dwordx4 v[108:111], v6, s[8:9] nt
  v_and_b32_dpp v48, v40, v44 row_newbcast:13 row_mask:0xf bank_mask:0xf
  v_and_b32_dpp v49, v40, v45 row_newbcast:13 row_mask:0xf bank_mask:0xf
  v_and_b32_dpp v50, v40, v46 row_newbcast:13 row_mask:0xf bank_mask:0xf
  v_and_b32_dpp v51, v40, v47 row_newbcast:13 row_mask:0xf bank_mask:0xf
  s_waitcnt vmcnt(20)
  v_mfma_f32_16x16x32_bf16 v[56:59], v[52:55], v[116:119], v[56:59]
  v_xor_b32 v7, s57, v6
  global_load_dwordx4 v[112:115], v7, s[8:9] nt
  v_and_b32_dpp v52, v40, v44 row_newbcast:12 row_mask:0xf bank_mask:0xf
  v_and_b32_dpp v53, v40, v45 row_newbcast:12 row_mask:0xf bank_mask:0xf
  v_and_b32_dpp v54, v40, v46 row_newbcast:12 row_mask:0xf bank_mask:0xf
  v_and_b32_dpp v55, v40, v47 row_newbcast:12 row_mask:0xf bank_mask:0xf
  s_waitcnt vmcnt(20)
  v_mfma_f32_16x16x32_bf16 v[56:59], v[48:51], v[120:123], v[56:59]
  v_xor_b32 v8, s56, v7
  global_load_dwordx4 v[116:119], v8, s[8:9] nt
  v_and_b32_dpp v48, v40, v44 row_newbcast:11 row_mask:0xf bank_mask:0xf
  v_and_b32_dpp v49, v40, v45 row_newbcast:11 row_mask:0xf bank_mask:0xf
  v_and_b32_dpp v50, v40, v46 row_newbcast:11 row_mask:0xf bank_mask:0xf
  v_and_b32_dpp v51, v40, v47 row_newbcast:11 row_mask:0xf bank_mask:0xf
  s_waitcnt vmcnt(20)
  v_mfma_f32_16x16x32_bf16 v[56:59], v[52:55], v[124:127], v[56:59]
  v_xor_b32 v5, 0x1f300, v8
  global_load_dwordx4 v[120:123], v5, s[8:9] nt
  v_and_b32_dpp v52, v40, v44 row_newbcast:10 row_mask:0xf bank_mask:0xf
  v_and_b32_dpp v53, v40, v45 row_newbcast:10 row_mask:0xf bank_mask:0xf
  v_and_b32_dpp v54, v40, v46 row_newbcast:10 row_mask:0xf bank_mask:0xf
  v_and_b32_dpp v55, v40, v47 row_newbcast:10 row_mask:0xf bank_mask:0xf
  s_waitcnt vmcnt(20)
  v_mfma_f32_16x16x32_bf16 v[56:59], v[48:51], v[128:131], v[56:59]
  v_xor_b32 v6, s56, v5
  global_load_dwordx4 v[124:127], v6, s[8:9] nt
  v_and_b32_dpp v48, v40, v44 row_newbcast:9 row_mask:0xf bank_mask:0xf
  v_and_b32_dpp v49, v40, v45 row_newbcast:9 row_mask:0xf bank_mask:0xf
  v_and_b32_dpp v50, v40, v46 row_newbcast:9 row_mask:0xf bank_mask:0xf
  v_and_b32_dpp v51, v40, v47 row_newbcast:9 row_mask:0xf bank_mask:0xf
  s_waitcnt vmcnt(20)
  v_mfma_f32_16x16x32_bf16 v[56:59], v[52:55], v[132:135], v[56:59]
  v_xor_b32 v7, s57, v6
  global_load_dwordx4 v[128:131], v7, s[8:9] nt
  v_and_b32_dpp v52, v40, v44 row_newbcast:8 row_mask:0xf bank_mask:0xf
  v_and_b32_dpp v53, v40, v45 row_newbcast:8 row_mask:0xf bank_mask:0xf
  v_and_b32_dpp v54, v40, v46 row_newbcast:8 row_mask:0xf bank_mask:0xf
  v_and_b32_dpp v55, v40, v47 row_newbcast:8 row_mask:0xf bank_mask:0xf
  s_waitcnt vmcnt(20)
  v_mfma_f32_16x16x32_bf16 v[56:59], v[48:51], v[136:139], v[56:59]
  v_xor_b32 v8, s56, v7
  global_load_dwordx4 v[132:135], v8, s[8:9] nt
  v_and_b32_dpp v48, v40, v44 row_newbcast:7 row_mask:0xf bank_mask:0xf
  v_and_b32_dpp v49, v40, v45 row_newbcast:7 row_mask:0xf bank_mask:0xf
  v_and_b32_dpp v50, v40, v46 row_newbcast:7 row_mask:0xf bank_mask:0xf
  v_and_b32_dpp v51, v40, v47 row_newbcast:7 row_mask:0xf bank_mask:0xf
  s_waitcnt vmcnt(20)
  v_mfma_f32_16x16x32_bf16 v[56:59], v[52:55], v[140:143], v[56:59]
  v_xor_b32 v5, s58, v8
  global_load_dwordx4 v[136:139], v5, s[8:9] nt
  v_and_b32_dpp v52, v40, v44 row_newbcast:6 row_mask:0xf bank_mask:0xf
  v_and_b32_dpp v53, v40, v45 row_newbcast:6 row_mask:0xf bank_mask:0xf
  v_and_b32_dpp v54, v40, v46 row_newbcast:6 row_mask:0xf bank_mask:0xf
  v_and_b32_dpp v55, v40, v47 row_newbcast:6 row_mask:0xf bank_mask:0xf
  s_waitcnt vmcnt(20)
  v_mfma_f32_16x16x32_bf16 v[56:59], v[48:51], v[144:147], v[56:59]
  v_xor_b32 v6, s56, v5
  global_load_dwordx4 v[140:143], v6, s[8:9] nt
  v_and_b32_dpp v48, v40, v44 row_newbcast:5 row_mask:0xf bank_mask:0xf
  v_and_b32_dpp v49, v40, v45 row_newbcast:5 row_mask:0xf bank_mask:0xf
  v_and_b32_dpp v50, v40, v46 row_newbcast:5 row_mask:0xf bank_mask:0xf
  v_and_b32_dpp v51, v40, v47 row_newbcast:5 row_mask:0xf bank_mask:0xf
  s_waitcnt vmcnt(20)
  v_mfma_f32_16x16x32_bf16 v[56:59], v[52:55], v[148:151], v[56:59]
  v_xor_b32 v7, s57, v6
  global_load_dwordx4 v[144:147], v7, s[8:9] nt
  v_and_b32_dpp v52, v40, v44 row_newbcast:4 row_mask:0xf bank_mask:0xf
  v_and_b32_dpp v53, v40, v45 row_newbcast:4 row_mask:0xf bank_mask:0xf
  v_and_b32_dpp v54, v40, v46 row_newbcast:4 row_mask:0xf bank_mask:0xf
  v_and_b32_dpp v55, v40, v47 row_newbcast:4 row_mask:0xf bank_mask:0xf
  s_waitcnt vmcnt(20)
  v_mfma_f32_16x16x32_bf16 v[56:59], v[48:51], v[152:155], v[56:59]
  v_xor_b32 v8, s56, v7
  global_load_dwordx4 v[148:151], v8, s[8:9] nt
  v_and_b32_dpp v48, v40, v44 row_newbcast:3 row_mask:0xf bank_mask:0xf
  v_and_b32_dpp v49, v40, v45 row_newbcast:3 row_mask:0xf bank_mask:0xf
  v_and_b32_dpp v50, v40, v46 row_newbcast:3 row_mask:0xf bank_mask:0xf
  v_and_b32_dpp v51, v40, v47 row_newbcast:3 row_mask:0xf bank_mask:0xf
  s_waitcnt vmcnt(20)
  v_mfma_f32_16x16x32_bf16 v[56:59], v[52:55], v[156:159], v[56:59]
  v_and_b32_dpp v52, v40, v44 row_newbcast:2 row_mask:0xf bank_mask:0xf
  v_and_b32_dpp v53, v40, v45 row_newbcast:2 row_mask:0xf bank_mask:0xf
  v_and_b32_dpp v54, v40, v46 row_newbcast:2 row_mask:0xf bank_mask:0xf
  v_and_b32_dpp v55, v40, v47 row_newbcast:2 row_mask:0xf bank_mask:0xf
  s_waitcnt vmcnt(19)
  v_mfma_f32_16x16x32_bf16 v[56:59], v[48:51], v[72:75], v[56:59]
  v_and_b32_dpp v48, v40, v44 row_newbcast:1 row_mask:0xf bank_mask:0xf
  v_and_b32_dpp v49, v40, v45 row_newbcast:1 row_mask:0xf bank_mask:0xf
  v_and_b32_dpp v50, v40, v46 row_newbcast:1 row_mask:0xf bank_mask:0xf
  v_and_b32_dpp v51, v40, v47 row_newbcast:1 row_mask:0xf bank_mask:0xf
  s_waitcnt vmcnt(18)
  v_mfma_f32_16x16x32_bf16 v[56:59], v[52:55], v[76:79], v[56:59]
  v_and_b32_dpp v52, v40, v44 row_newbcast:0 row_mask:0xf bank_mask:0xf
  v_and_b32_dpp v53, v40, v45 row_newbcast:0 row_mask:0xf bank_mask:0xf
  v_and_b32_dpp v54, v40, v46 row_newbcast:0 row_mask:0xf bank_mask:0xf
  v_and_b32_dpp v55, v40, v47 row_newbcast:0 row_mask:0xf bank_mask:0xf
  s_waitcnt vmcnt(17)
  v_mfma_f32_16x16x32_bf16 v[56:59], v[48:51], v[80:83], v[56:59]
  v_and_b32_dpp v48, v41, v44 row_newbcast:15 row_mask:0xf bank_mask:0xf
  v_and_b32_dpp v49, v41, v45 row_newbcast:15 row_mask:0xf bank_mask:0xf
  v_and_b32_dpp v50, v41, v46 row_newbcast:15 row_mask:0xf bank_mask:0xf
  v_and_b32_dpp v51, v41, v47 row_newbcast:15 row_mask:0xf bank_mask:0xf
  s_waitcnt vmcnt(16)
  v_mfma_f32_16x16x32_bf16 v[56:59], v[52:55], v[84:87], v[56:59]
  v_and_b32_dpp v52, v41, v44 row_newbcast:14 row_mask:0xf bank_mask:0xf
  v_and_b32_dpp v53, v41, v45 row_newbcast:14 row_mask:0xf bank_mask:0xf
  v_and_b32_dpp v54, v41, v46 row_newbcast:14 row_mask:0xf bank_mask:0xf
  v_and_b32_dpp v55, v41, v47 row_newbcast:14 row_mask:0xf bank_mask:0xf
  s_waitcnt vmcnt(15)
  v_mfma_f32_16x16x32_bf16 v[56:59], v[48:51], v[88:91], v[56:59]
  v_and_b32_dpp v48, v41, v44 row_newbcast:13 row_mask:0xf bank_mask:0xf
  v_and_b32_dpp v49, v41, v45 row_newbcast:13 row_mask:0xf bank_mask:0xf
  v_and_b32_dpp v50, v41, v46 row_newbcast:13 row_mask:0xf bank_mask:0xf
  v_and_b32_dpp v51, v41, v47 row_newbcast:13 row_mask:0xf bank_mask:0xf
  s_waitcnt vmcnt(14)
  v_mfma_f32_16x16x32_bf16 v[56:59], v[52:55], v[92:95], v[56:59]
  v_and_b32_dpp v52, v41, v44 row_newbcast:12 row_mask:0xf bank_mask:0xf
  v_and_b32_dpp v53, v41, v45 row_newbcast:12 row_mask:0xf bank_mask:0xf
  v_and_b32_dpp v54, v41, v46 row_newbcast:12 row_mask:0xf bank_mask:0xf
  v_and_b32_dpp v55, v41, v47 row_newbcast:12 row_mask:0xf bank_mask:0xf
  s_waitcnt vmcnt(13)
  v_mfma_f32_16x16x32_bf16 v[56:59], v[48:51], v[96:99], v[56:59]
  v_and_b32_dpp v48, v41, v44 row_newbcast:11 row_mask:0xf bank_mask:0xf
  v_and_b32_dpp v49, v41, v45 row_newbcast:11 row_mask:0xf bank_mask:0xf
  v_and_b32_dpp v50, v41, v46 row_newbcast:11 row_mask:0xf bank_mask:0xf
  v_and_b32_dpp v51, v41, v47 row_newbcast:11 row_mask:0xf bank_mask:0xf
  s_waitcnt vmcnt(12)
  v_mfma_f32_16x16x32_bf16 v[56:59], v[52:55], v[100:103], v[56:59]
  v_and_b32_dpp v52, v41, v44 row_newbcast:10 row_mask:0xf bank_mask:0xf
  v_and_b32_dpp v53, v41, v45 row_newbcast:10 row_mask:0xf bank_mask:0xf
  v_and_b32_dpp v54, v41, v46 row_newbcast:10 row_mask:0xf bank_mask:0xf
  v_and_b32_dpp v55, v41, v47 row_newbcast:10 row_mask:0xf bank_mask:0xf
  s_waitcnt vmcnt(11)
  v_mfma_f32_16x16x32_bf16 v[56:59], v[48:51], v[104:107], v[56:59]
  v_and_b32_dpp v48, v41, v44 row_newbcast:9 row_mask:0xf bank_mask:0xf
  v_and_b32_dpp v49, v41, v45 row_newbcast:9 row_mask:0xf bank_mask:0xf
  v_and_b32_dpp v50, v41, v46 row_newbcast:9 row_mask:0xf bank_mask:0xf
  v_and_b32_dpp v51, v41, v47 row_newbcast:9 row_mask:0xf bank_mask:0xf
  s_waitcnt vmcnt(10)
  v_mfma_f32_16x16x32_bf16 v[56:59], v[52:55], v[108:111], v[56:59]
  v_and_b32_dpp v52, v41, v44 row_newbcast:8 row_mask:0xf bank_mask:0xf
  v_and_b32_dpp v53, v41, v45 row_newbcast:8 row_mask:0xf bank_mask:0xf
  v_and_b32_dpp v54, v41, v46 row_newbcast:8 row_mask:0xf bank_mask:0xf
  v_and_b32_dpp v55, v41, v47 row_newbcast:8 row_mask:0xf bank_mask:0xf
  s_waitcnt vmcnt(9)
  v_mfma_f32_16x16x32_bf16 v[56:59], v[48:51], v[112:115], v[56:59]
  v_and_b32_dpp v48, v41, v44 row_newbcast:7 row_mask:0xf bank_mask:0xf
  v_and_b32_dpp v49, v41, v45 row_newbcast:7 row_mask:0xf bank_mask:0xf
  v_and_b32_dpp v50, v41, v46 row_newbcast:7 row_mask:0xf bank_mask:0xf
  v_and_b32_dpp v51, v41, v47 row_newbcast:7 row_mask:0xf bank_mask:0xf
  s_waitcnt vmcnt(8)
  v_mfma_f32_16x16x32_bf16 v[56:59], v[52:55], v[116:119], v[56:59]
  v_and_b32_dpp v52, v41, v44 row_newbcast:6 row_mask:0xf bank_mask:0xf
  v_and_b32_dpp v53, v41, v45 row_newbcast:6 row_mask:0xf bank_mask:0xf
  v_and_b32_dpp v54, v41, v46 row_newbcast:6 row_mask:0xf bank_mask:0xf
  v_and_b32_dpp v55, v41, v47 row_newbcast:6 row_mask:0xf bank_mask:0xf
  s_waitcnt vmcnt(7)
  v_mfma_f32_16x16x32_bf16 v[56:59], v[48:51], v[120:123], v[56:59]
L_pre:
  ds_read_b128 v[16:19], v61 offset:16
  ds_read_b64 v[28:29], v64 offset:256
  s_waitcnt lgkmcnt(0)
  v_max_u32 v11, v16, v17
  v_max3_u32 v11, v18, v19, v11
  s_nop 0
  v_readfirstlane_b32 s29, v11
  s_cmp_eq_u32 s29, -1
  s_cbranch_scc1 L_pre
  s_ashr_i32 s29, s29, 31
  s_or_b32 s29, s29, 3
  v_and_b32_dpp v48, v41, v44 row_newbcast:5 row_mask:0xf bank_mask:0xf
  v_and_b32_dpp v49, v41, v45 row_newbcast:5 row_mask:0xf bank_mask:0xf
  v_and_b32_dpp v50, v41, v46 row_newbcast:5 row_mask:0xf bank_mask:0xf
  v_and_b32_dpp v51, v41, v47 row_newbcast:5 row_mask:0xf bank_mask:0xf
  s_waitcnt vmcnt(6)
  v_mfma_f32_16x16x32_bf16 v[56:59], v[52:55], v[124:127], v[56:59]
  v_and_b32_dpp v52, v41, v44 row_newbcast:4 row_mask:0xf bank_mask:0xf
  v_and_b32_dpp v53, v41, v45 row_newbcast:4 row_mask:0xf bank_mask:0xf
  v_and_b32_dpp v54, v41, v46 row_newbcast:4 row_mask:0xf bank_mask:0xf
  v_and_b32_dpp v55, v41, v47 row_newbcast:4 row_mask:0xf bank_mask:0xf
  s_waitcnt vmcnt(5)
  v_mfma_f32_16x16x32_bf16 v[56:59], v[48:51], v[128:131], v[56:59]
  v_and_b32_dpp v48, v41, v44 row_newbcast:3 row_mask:0xf bank_mask:0xf
  v_and_b32_dpp v49, v41, v45 row_newbcast:3 row_mask:0xf bank_mask:0xf
  v_and_b32_dpp v50, v41, v46 row_newbcast:3 row_mask:0xf bank_mask:0xf
  v_and_b32_dpp v51, v41, v47 row_newbcast:3 row_mask:0xf bank_mask:0xf
  s_waitcnt vmcnt(4)
  v_mfma_f32_16x16x32_bf16 v[56:59], v[52:55], v[132:135], v[56:59]
  v_and_b32_dpp v52, v41, v44 row_newbcast:2 row_mask:0xf bank_mask:0xf
  v_and_b32_dpp v53, v41, v45 row_newbcast:2 row_mask:0xf bank_mask:0xf
  v_and_b32_dpp v54, v41, v46 row_newbcast:2 row_mask:0xf bank_mask:0xf
  v_and_b32_dpp v55, v41, v47 row_newbcast:2 row_mask:0xf bank_mask:0xf
  s_waitcnt vmcnt(3)
  v_mfma_f32_16x16x32_bf16 v[56:59], v[48:51], v[136:139], v[56:59]
  v_and_b32_dpp v48, v41, v44 row_newbcast:1 row_mask:0xf bank_mask:0xf
  v_and_b32_dpp v49, v41, v45 row_newbcast:1 row_mask:0xf bank_mask:0xf
  v_and_b32_dpp v50, v41, v46 row_newbcast:1 row_mask:0xf bank_mask:0xf
  v_and_b32_dpp v51, v41, v47 row_newbcast:1 row_mask:0xf bank_mask:0xf
  s_waitcnt vmcnt(2)
  v_mfma_f32_16x16x32_bf16 v[56:59], v[52:55], v[140:143], v[56:59]
  global_load_dwordx4 v[68:71], v14, s[18:19] sc1
  v_and_b32_dpp v52, v41, v44 row_newbcast:0 row_mask:0xf bank_mask:0xf
  v_and_b32_dpp v53, v41, v45 row_newbcast:0 row_mask:0xf bank_mask:0xf
  v_and_b32_dpp v54, v41, v46 row_newbcast:0 row_mask:0xf bank_mask:0xf
  v_and_b32_dpp v55, v41, v47 row_newbcast:0 row_mask:0xf bank_mask:0xf
  s_waitcnt vmcnt(2)
  v_mfma_f32_16x16x32_bf16 v[56:59], v[48:51], v[144:147], v[56:59]
  s_waitcnt vmcnt(1)
  v_mfma_f32_16x16x32_bf16 v[56:59], v[52:55], v[148:151], v[56:59]
  s_mov_b32 exec_hi, 0
  s_nop 6
  ds_write_b128 v63, v[56:59] offset:2304
  s_mov_b32 exec_lo, 1
  ds_add_rtn_u32 v10, v61, v60 offset:8
  s_mov_b64 exec, -1
  ds_read_b64 v[20:21], v64 offset:2304
  ds_read_b64 v[22:23], v64 offset:2816
  ds_read_b64 v[24:25], v64 offset:3328
  ds_read_b64 v[26:27], v64 offset:3840
  s_waitcnt lgkmcnt(4)
  v_readfirstlane_b32 s28, v10
  s_waitcnt lgkmcnt(3)
  v_pk_fma_f32 v[20:21], v[20:21], v[16:17], v[28:29] op_sel_hi:[1,0,1]
  s_waitcnt lgkmcnt(2)
  v_pk_fma_f32 v[20:21], v[22:23], v[16:17], v[20:21] op_sel:[0,1,0] op_sel_hi:[1,1,1]
  s_cmp_lg_u32 s28, s29
  s_waitcnt lgkmcnt(1)
  v_pk_fma_f32 v[20:21], v[24:25], v[18:19], v[20:21] op_sel_hi:[1,0,1]
  s_cbranch_scc1 L_slow
  s_waitcnt lgkmcnt(0)
  v_pk_fma_f32 v[20:21], v[26:27], v[18:19], v[20:21] op_sel:[0,1,0] op_sel_hi:[1,1,1]
  v_min_u32 v20, -2, v20
  global_store_dwordx2 v65, v[20:21], s[18:19]
  s_waitcnt vmcnt(1)
  global_load_dwordx2 v[160:161], v67, s[18:19] sc1
  v_max_u32 v11, v68, v70
  v_cmp_eq_u32 vcc, -1, v11
  s_cbranch_vccnz L_mlr
L_mlok:
  v_max_f32 v10, v68, v70
  s_nop 1
  v_max_f32_dpp v11, v10, v10 row_ror:8 row_mask:0xf bank_mask:0xf
  v_max_f32_dpp v10, v10, v10 row_ror:8 row_mask:0xf bank_mask:0xf
  global_load_dwordx2 v[162:163], v67, s[18:19] sc1
  s_nop 0
  v_permlane16_swap_b32 v11, v10
  v_max_f32 v10, v10, v11
  v_sub_f32 v32, v68, v10
  v_sub_f32 v33, v70, v10
  v_exp_f32 v32, v32
  v_exp_f32 v33, v33
  v_mul_f32 v10, v32, v69
  v_fmac_f32 v10, v33, v71
  s_nop 1
  v_add_f32_dpp v11, v10, v10 row_ror:8 row_mask:0xf bank_mask:0xf
  v_add_f32_dpp v10, v10, v10 row_ror:8 row_mask:0xf bank_mask:0xf
  global_load_dwordx2 v[164:165], v67, s[18:19] sc1
  s_nop 0
  v_permlane16_swap_b32 v11, v10
  v_add_f32 v10, v10, v11
  v_rcp_f32 v10, v10
  s_nop 0
  v_mul_f32 v32, v32, v10
  v_mul_f32 v33, v33, v10
L_poll:
  global_load_dwordx2 v[166:167], v67, s[18:19] sc1
  s_waitcnt vmcnt(3)
  v_cmp_eq_u32 vcc, -1, v160
  v_permlane32_swap_b32 v160, v161
  v_mul_f32 v10, v160, v32
  v_fmac_f32 v10, v161, v33
  s_cbranch_vccnz L_nx0
  s_nop 0
  v_add_f32_dpp v11, v10, v10 row_ror:8 row_mask:0xf bank_mask:0xf
  v_add_f32_dpp v12, v10, v10 row_ror:8 row_mask:0xf bank_mask:0xf
  s_nop 1
  v_permlane16_swap_b32 v11, v12
  v_add_f32 v10, v11, v12
  v_cvt_pk_bf16_f32 v10, v10, v10
  global_store_short v15, v10, s[32:33]
  s_endpgm
L_nx0:
  global_load_dwordx2 v[160:161], v67, s[18:19] sc1
  s_waitcnt vmcnt(3)
  v_cmp_eq_u32 vcc, -1, v162
  v_permlane32_swap_b32 v162, v163
  v_mul_f32 v10, v162, v32
  v_fmac_f32 v10, v163, v33
  s_cbranch_vccnz L_nx1
  s_nop 0
  v_add_f32_dpp v11, v10, v10 row_ror:8 row_mask:0xf bank_mask:0xf
  v_add_f32_dpp v12, v10, v10 row_ror:8 row_mask:0xf bank_mask:0xf
  s_nop 1
  v_permlane16_swap_b32 v11, v12
  v_add_f32 v10, v11, v12
  v_cvt_pk_bf16_f32 v10, v10, v10
  global_store_short v15, v10, s[32:33]
  s_endpgm
L_nx1:
  global_load_dwordx2 v[162:163], v67, s[18:19] sc1
  s_waitcnt vmcnt(3)
  v_cmp_eq_u32 vcc, -1, v164
  v_permlane32_swap_b32 v164, v165
  v_mul_f32 v10, v164, v32
  v_fmac_f32 v10, v165, v33
  s_cbranch_vccnz L_nx2
  s_nop 0
  v_add_f32_dpp v11, v10, v10 row_ror:8 row_mask:0xf bank_mask:0xf
  v_add_f32_dpp v12, v10, v10 row_ror:8 row_mask:0xf bank_mask:0xf
  s_nop 1
  v_permlane16_swap_b32 v11, v12
  v_add_f32 v10, v11, v12
  v_cvt_pk_bf16_f32 v10, v10, v10
  global_store_short v15, v10, s[32:33]
  s_endpgm
L_nx2:
  global_load_dwordx2 v[164:165], v67, s[18:19] sc1
  s_waitcnt vmcnt(3)
  v_cmp_eq_u32 vcc, -1, v166
  v_permlane32_swap_b32 v166, v167
  v_mul_f32 v10, v166, v32
  v_fmac_f32 v10, v167, v33
  s_cbranch_vccnz L_poll
  s_nop 0
  v_add_f32_dpp v11, v10, v10 row_ror:8 row_mask:0xf bank_mask:0xf
  v_add_f32_dpp v12, v10, v10 row_ror:8 row_mask:0xf bank_mask:0xf
  s_nop 1
  v_permlane16_swap_b32 v11, v12
  v_add_f32 v10, v11, v12
  v_cvt_pk_bf16_f32 v10, v10, v10
  global_store_short v15, v10, s[32:33]
  s_endpgm
L_mlr:
  s_lshl_b32 s28, s25, 2
  v_mov_b32 v13, s28
  s_mov_b32 s30, 0
L_mlr2:
  global_load_dwordx4 v[68:71], v14, s[18:19] sc1
  s_add_u32 s30, s30, 1
  s_waitcnt vmcnt(0)
  global_load_dwordx2 v[160:161], v67, s[18:19] sc1
  v_max_u32 v11, v68, v70
  v_cmp_eq_u32 vcc, -1, v11
  s_cbranch_vccz L_mlok
  s_and_b32 s28, s30, 7
  s_cbranch_scc1 L_mlr2
  global_load_dword v10, v13, s[16:17] offset:128 sc1
  s_waitcnt vmcnt(0)
  v_readfirstlane_b32 s28, v10
  s_cmp_eq_u32 s28, 0
  s_cbranch_scc1 L_mlr2
  s_branch L_slow2
L_slow:
  s_waitcnt lgkmcnt(0)
  s_cmp_lg_u32 s28, 3
  s_cbranch_scc1 L_fin
  v_pk_fma_f32 v[20:21], v[26:27], v[18:19], v[20:21] op_sel:[0,1,0] op_sel_hi:[1,1,1]
  v_sub_f32 v20, 0, v20
  v_sub_f32 v21, 0, v21
  s_lshl_b32 s28, s25, 2
  v_mov_b32 v13, s28
L_slow2:
  ds_read_b64 v[16:17], v61 offset:32
  v_add_u32 v65, 1048576, v65
  v_add_u32 v67, 1048576, v67
  v_add_u32 v14, 1048576, v14
  global_store_dwordx2 v65, v[20:21], s[18:19] sc1
  s_and_b32 s29, s22, 7
  s_and_b32 s28, s29, 3
  s_lshl_b32 s28, s28, 4
  s_lshr_b32 s30, s29, 2
  s_lshl_b32 s30, s30, 3
  s_add_u32 s28, s28, s30
  s_lshl_b32 s30, s25, 13
  s_add_u32 s28, s28, s30
  s_add_u32 s28, s28, 1052672
  v_mov_b32 v12, s28
  s_lshl_b32 s29, 1, s29
  v_mov_b32 v10, s29
  s_mov_b64 exec, 1
  s_waitcnt lgkmcnt(0)
  global_store_dwordx2 v12, v[16:17], s[18:19] sc1
  s_waitcnt vmcnt(0)
  global_atomic_or v13, v10, s[16:17] offset:128 sc1
  s_mov_b64 exec, -1
L_sw:
  global_load_dword v10, v13, s[16:17] offset:128 sc1
  s_waitcnt vmcnt(0)
  v_readfirstlane_b32 s29, v10
  s_cmp_lg_u32 s29, 0xff
  s_cbranch_scc1 L_sw
  global_load_dwordx4 v[68:71], v14, s[18:19] sc1
  global_load_dwordx2 v[160:161], v67, s[18:19] sc1
  s_waitcnt vmcnt(0)
  v_max_f32 v10, v68, v70
  s_nop 1
  v_max_f32_dpp v11, v10, v10 row_ror:8 row_mask:0xf bank_mask:0xf
  v_max_f32_dpp v10, v10, v10 row_ror:8 row_mask:0xf bank_mask:0xf
  s_nop 1
  v_permlane16_swap_b32 v11, v10
  v_max_f32 v10, v10, v11
  v_sub_f32 v32, v68, v10
  v_sub_f32 v33, v70, v10
  v_exp_f32 v32, v32
  v_exp_f32 v33, v33
  v_mul_f32 v10, v32, v69
  v_fmac_f32 v10, v33, v71
  s_nop 1
  v_add_f32_dpp v11, v10, v10 row_ror:8 row_mask:0xf bank_mask:0xf
  v_add_f32_dpp v10, v10, v10 row_ror:8 row_mask:0xf bank_mask:0xf
  s_nop 1
  v_permlane16_swap_b32 v11, v10
  v_add_f32 v10, v10, v11
  v_rcp_f32 v10, v10
  s_nop 0
  v_mul_f32 v32, v32, v10
  v_mul_f32 v33, v33, v10
  v_permlane32_swap_b32 v160, v161
  v_mul_f32 v10, v160, v32
  v_fmac_f32 v10, v161, v33
  s_nop 1
  v_add_f32_dpp v11, v10, v10 row_ror:8 row_mask:0xf bank_mask:0xf
  v_add_f32_dpp v12, v10, v10 row_ror:8 row_mask:0xf bank_mask:0xf
  s_nop 1
  v_permlane16_swap_b32 v11, v12
  v_add_f32 v10, v11, v12
  v_cvt_pk_bf16_f32 v10, v10, v10
  global_store_short v15, v10, s[32:33]
  s_endpgm
.org L_text0+8192, 0
L_H:
  s_load_dwordx4 s[12:15], s[0:1], 32
  s_load_dwordx2 s[32:33], s[0:1], 48
  s_load_dwordx4 s[16:19], s[0:1], 56
  s_getreg_b32 s37, hwreg(HW_REG_XCC_ID)
  s_and_b32 s37, s37, 15
  s_add_u32 s37, s37, 1
  s_and_b32 s23, s22, 7
  v_mov_b32 v61, 0
  s_lshl_b32 s28, s25, 2
  v_mov_b32 v1, s28
  s_lshl_b32 s27, s25, 13
  v_lshlrev_b32 v2, 3, v9
  s_mov_b32 s31, 0x3e0293ee
  s_lshl_b32 s28, s25, 8
  v_lshl_add_u32 v4, v9, 2, s28
  v_mov_b32 v16, -1
  v_mov_b32 v17, -1
  s_lshl_b32 s28, s23, 6
  s_add_u32 s28, s28, s27
  v_and_b32 v8, 7, v0
  v_lshl_add_u32 v10, v8, 3, s28
  v_lshrrev_b32 v11, 3, v9
  v_lshl_add_u32 v10, v11, 9, v10
  s_cmp_lg_u32 s23, 0
  s_cbranch_scc1 L_Hp
  s_add_u32 s28, s27, 4096
  v_lshl_add_u32 v5, v8, 3, s28
  s_mov_b64 exec, 0xff
  s_waitcnt lgkmcnt(0)
  global_store_dwordx2 v5, v[16:17], s[18:19]
  s_mov_b64 exec, -1
  global_store_dwordx2 v10, v[16:17], s[18:19]
  global_load_dword v20, v4, s[4:5]
  global_load_dword v21, v4, s[10:11]
  global_load_dword v22, v4, s[12:13]
  global_load_ushort v23, v61, s[14:15]
  v_mov_b32 v6, s37
  s_barrier
  s_lshl_b32 s28, s25, 2
  s_mov_b32 s29, s37
  s_waitcnt vmcnt(0)
  s_atomic_add s29, s[16:17], s28 glc
  s_waitcnt vmcnt(0) lgkmcnt(0)
  v_dot2_f32_bf16 v24, v20, v21, 0
  v_lshlrev_b32 v23, 16, v23
  v_sub_f32 v23, 1.0, v23
  v_mul_f32 v23, 0xceabfb8f, v23
  v_add_f32_dpp v24, v24, v24 row_ror:8 row_mask:0xf bank_mask:0xf
  s_nop 1
  v_add_f32_dpp v24, v24, v24 row_ror:4 row_mask:0xf bank_mask:0xf
  s_nop 1
  v_add_f32_dpp v24, v24, v24 row_ror:2 row_mask:0xf bank_mask:0xf
  s_nop 1
  v_add_f32_dpp v24, v24, v24 row_ror:1 row_mask:0xf bank_mask:0xf
  v_mov_b32 v16, v24
  s_nop 1
  v_permlane16_swap_b32 v16, v24
  v_add_f32 v24, v24, v16
  v_mov_b32 v16, v24
  s_nop 1
  v_permlane32_swap_b32 v16, v24
  v_add_f32 v24, v24, v16
  s_nop 0
  v_readfirstlane_b32 s28, v24
  v_lshlrev_b32 v26, 16, v22
  v_and_b32 v27, 0xffff0000, v22
  v_mov_b32 v24, s28
  v_fma_f32 v24, v24, s31, v23
  s_branch L_Hs
L_Hp:
  v_mov_b32 v24, 0xff800000
  v_mov_b32 v26, 0
  v_mov_b32 v27, 0
  s_waitcnt lgkmcnt(0)
  global_store_dwordx2 v10, v[16:17], s[18:19]
  s_barrier
  s_waitcnt vmcnt(0)
L_Hs:
  ds_read_b64 v[16:17], v61 offset:48
  s_waitcnt lgkmcnt(0)
  v_readfirstlane_b32 s29, v16
  s_cmp_lt_i32 s29, 3
  s_cbranch_scc1 L_Hs
  v_readfirstlane_b32 s28, v17
  s_cmp_eq_u32 s28, s37
  s_cselect_b32 s36, 0, 0x80000000
  ds_read_b64 v[28:29], v2 offset:256
  ds_read_b64 v[30:31], v2 offset:768
  ds_read_b64 v[32:33], v2 offset:1280
  ds_read_b64 v[34:35], v2 offset:1792
  s_and_b32 s28, s23, 3
  s_lshl_b32 s28, s28, 4
  s_lshr_b32 s29, s23, 2
  s_lshl_b32 s29, s29, 3
  s_add_u32 s28, s28, s29
  s_add_u32 s28, s28, s27
  s_add_u32 s28, s28, 4096
  v_mov_b32 v7, s28
  s_lshl_b32 s28, s23, 9
  s_add_u32 s28, s28, s27
  v_add_u32 v3, s28, v2
  s_waitcnt lgkmcnt(0)
  v_max3_f32 v40, v28, v30, v32
  v_max3_f32 v40, v40, v34, v24
  v_sub_f32 v36, v28, v40
  v_sub_f32 v37, v30, v40
  v_sub_f32 v38, v32, v40
  v_sub_f32 v39, v34, v40
  v_sub_f32 v24, v24, v40
  v_exp_f32 v36, v36
  v_exp_f32 v37, v37
  v_exp_f32 v38, v38
  v_exp_f32 v39, v39
  v_exp_f32 v24, v24
  v_mul_f32 v41, v36, v29
  v_fmac_f32 v41, v37, v31
  v_fmac_f32 v41, v38, v33
  v_fmac_f32 v41, v39, v35
  s_nop 1
  v_add_f32_dpp v41, v41, v41 row_ror:8 row_mask:0xf bank_mask:0xf
  s_nop 1
  v_add_f32_dpp v41, v41, v41 row_ror:4 row_mask:0xf bank_mask:0xf
  s_nop 1
  v_add_f32_dpp v41, v41, v41 row_ror:2 row_mask:0xf bank_mask:0xf
  s_nop 1
  v_add_f32_dpp v41, v41, v41 row_ror:1 row_mask:0xf bank_mask:0xf
  v_mov_b32 v16, v41
  s_nop 1
  v_permlane16_swap_b32 v16, v41
  v_add_f32 v41, v41, v16
  v_mov_b32 v16, v41
  s_nop 1
  v_permlane32_swap_b32 v16, v41
  v_add_f32 v41, v41, v16
  v_add_f32 v41, v41, v24
  v_min_u32 v40, -2, v40
  s_cmp_eq_u32 s36, 0
  s_cselect_b64 exec, 1, 0
  global_store_dwordx2 v7, v[40:41], s[18:19]
  s_mov_b64 exec, -1
  v_xor_b32 v24, s36, v24
  v_mul_f32 v26, v26, v24
  v_mul_f32 v27, v27, v24
  v_and_b32 v36, 0x7fffffff, v36
  v_and_b32 v37, 0x7fffffff, v37
  v_and_b32 v38, 0x7fffffff, v38
  v_and_b32 v39, 0x7fffffff, v39
  ds_write_b64 v2, v[26:27] offset:256
  v_min_u32 v36, 0x7ffffffe, v36
  v_min_u32 v37, 0x7ffffffe, v37
  v_min_u32 v38, 0x7ffffffe, v38
  v_min_u32 v39, 0x7ffffffe, v39
  v_or_b32 v36, s36, v36
  v_or_b32 v37, s36, v37
  v_or_b32 v38, s36, v38
  v_or_b32 v39, s36, v39
  s_mov_b64 exec, 1
  ds_write_b64 v61, v[40:41] offset:32
  ds_write_b128 v61, v[36:39] offset:16
  s_mov_b64 exec, -1
  global_load_dwordx2 v[44:45], v3, s[18:19] sc1
L_fin:
L_end:
  s_endpgm
.section .rodata,"a"
.p2align 6
.amdhsa_kernel standalone__tree_speculative_verify_tree_attention_over_candidate_token_tree__decode_kernel
  .amdhsa_next_free_vgpr 168
  .amdhsa_next_free_sgpr 64
  .amdhsa_accum_offset 168
  .amdhsa_group_segment_fixed_size 0
  .amdhsa_kernarg_size 72
  .amdhsa_user_sgpr_count 2
  .amdhsa_user_sgpr_kernarg_segment_ptr 1
  .amdhsa_system_sgpr_workgroup_id_x 1
.end_amdhsa_kernel
```
